```python
import torch

def _softmax(x, axis=-1):
    return torch.softmax(x, dim=axis)
def _gelu(x):
    return torch.nn.functional.gelu(x, approximate="tanh")
def _silu(x):
    return torch.nn.functional.silu(x)
def _sigmoid(x):
    return torch.sigmoid(x)
def _layernorm(x, axis=-1, eps=1e-5):
    m = x.mean(dim=axis, keepdim=True)
    v = x.var(dim=axis, keepdim=True, unbiased=False)
    return (x - m) / torch.sqrt(v + eps)
def _scatter_add(tgt, idx, src, axis=0):
    return tgt.clone().index_add_(axis, idx, src)
def _segment_sum(src, seg, n):
    out = torch.zeros((n,) + src.shape[1:], dtype=src.dtype)
    return out.index_add_(0, seg, src)
def _pad(x, pw):
    flat = tuple(v for pair in reversed(pw) for v in pair)
    return torch.nn.functional.pad(x, flat)

kernel_name = 'standalone__sliding_local_strided__prompt'

def setup_inputs():

    _w = (lambda a: (lambda t: t.to(torch.bfloat16) if t.is_floating_point() else t)(torch.as_tensor(a)))
    B, H, S, D = 1, 16, 2048, 256
    return {
        "q": _w((lambda *s: torch.randn(*s, dtype=torch.bfloat16) * 0.8)(B, H, S, D)),
        "k": _w((lambda *s: torch.randn(*s, dtype=torch.bfloat16) * 0.8)(B, H, S, D)),
        "v": _w((lambda *s: torch.randn(*s, dtype=torch.bfloat16) * 0.05)(B, H, S, D)),
    }

def reference(q, k, v):
    B, H, S, D = q.shape
    W, dil = 8, 4
    scale = D ** -0.5
    pos = torch.arange(S)
    kidx = pos[:, None] - torch.arange(W)[None, :] * dil
    valid = kidx >= 0
    kidx = torch.where(valid, kidx, torch.zeros_like(kidx))
    idx = torch.reshape(kidx, (1, 1, S * W, 1))
    idx = (lambda x, n, axis: torch.repeat_interleave(x, n, dim=axis))(idx, B, 0)
    idx = (lambda x, n, axis: torch.repeat_interleave(x, n, dim=axis))(idx, H, 1)
    idx = (lambda x, n, axis: torch.repeat_interleave(x, n, dim=axis))(idx, D, 3)
    kg = torch.reshape((lambda x, i, axis: torch.take_along_dim(x, i, dim=axis))(k, idx, 2), (B, H, S, W, D))
    vg = torch.reshape((lambda x, i, axis: torch.take_along_dim(x, i, dim=axis))(v, idx, 2), (B, H, S, W, D))
    scores = torch.einsum("bhsd,bhswd->bhsw", q, kg) * scale
    mask_f = (lambda x, dt: x.to(dt))(valid, q.dtype)[None, None, :, :]
    scores = scores + (mask_f - 1.0) * 1e9
    p = _softmax(scores, axis=-1)
    return torch.einsum("bhsw,bhswd->bhsd", p, vg)
```

```asm
; @launch grid=(256,1,1) block=(256,1,1) lds=0
.amdgcn_target "amdgcn-amd-amdhsa--gfx950"
.text
.p2align 12
.fill 512, 4, 0xbf810000
.globl standalone__sliding_local_strided__prompt_kernel
.p2align 8
.type standalone__sliding_local_strided__prompt_kernel,@function
standalone__sliding_local_strided__prompt_kernel:
    s_load_dwordx2 s[12:13], s[0:1], 0
    s_cmpk_ge_u32 s2, 256
    s_cbranch_scc1 L_end
    s_getpc_b64 s[4:5]
L_pc:
    v_mad_u64_u32 v[16:17], vcc, v0, 18, s[4:5]
    global_load_ubyte v24, v[16:17], off
    s_and_b32 s3, s2, 7
    s_lshl_b32 s3, s3, 21
    s_lshr_b32 s6, s2, 3
    s_lshl_b32 s6, s6, 16
    s_or_b32 s3, s3, s6
    s_bitcmp1_b32 s2, 3
    s_cselect_b32 s7, 0xe000, 0
    s_or_b32 s50, s3, s7
    v_and_b32 v10, 3, v0
    v_and_b32 v11, 12, v0
    v_and_b32 v12, 48, v0
    v_and_b32 v13, 0xc0, v0
    v_lshlrev_b32 v10, 4, v10
    v_lshlrev_b32 v13, 3, v13
    v_lshl_add_u32 v1, v11, 9, v10
    v_lshl_add_u32 v14, v12, 2, v13
    v_add_u32 v1, v1, v14
    s_bfm_b32 s14, 1, 24
    s_mov_b32 s15, 0x20000
    s_xor_b32 s55, s50, 0xa000
    s_waitcnt lgkmcnt(0)
    buffer_load_dwordx4 a[120:123], v1, s[12:15], s55 offen nt
    s_xor_b32 s54, s50, 0x8000
    buffer_load_dwordx4 a[124:127], v1, s[12:15], s55 offen offset:256 nt
    s_xor_b32 s53, s50, 0x6000
    buffer_load_dwordx4 a[112:115], v1, s[12:15], s54 offen nt
    s_xor_b32 s52, s50, 0x4000
    buffer_load_dwordx4 a[116:119], v1, s[12:15], s54 offen offset:256 nt
    s_xor_b32 s51, s50, 0x2000
    buffer_load_dwordx4 a[104:107], v1, s[12:15], s53 offen nt
    s_xor_b32 s57, s50, 0xe000
    buffer_load_dwordx4 a[108:111], v1, s[12:15], s53 offen offset:256 nt
    s_xor_b32 s56, s50, 0xc000
    s_load_dwordx2 s[16:17], s[0:1], 8
    s_load_dwordx2 s[20:21], s[0:1], 16
    s_load_dwordx2 s[24:25], s[0:1], 24
    s_mov_b64 s[18:19], s[14:15]
    s_mov_b64 s[22:23], s[14:15]
    s_mov_b64 s[26:27], s[14:15]
    v_lshl_add_u32 v2, v12, 7, v13
    v_and_b32 v14, 15, v0
    v_lshl_add_u32 v2, v14, 4, v2
    s_and_b32 s6, s6, 0xf0000
    s_cselect_b32 s8, 0, 0x100000
    s_cselect_b32 s34, 0, 0x11111111
    s_add_u32 s8, s8, s3
    s_sub_u32 s9, s8, 0x2000
    s_sub_u32 s8, s8, 0x4000
    s_mov_b32 s10, s9
    s_mov_b32 s11, s8
    s_mul_i32 s32, s34, 3
    s_mov_b32 s35, s34
    s_mov_b32 s4, 0x000f0000
    s_mov_b32 s5, 0x0fff00ff
    s_and_b32 s33, s32, s5
    s_and_b32 s32, s32, s4
    s_bitcmp1_b32 s2, 3
    s_cselect_b64 s[30:31], -1, 0
    s_cselect_b64 s[40:41], s[50:51], s[8:9]
    s_cselect_b64 s[42:43], s[52:53], s[50:51]
    s_cselect_b64 s[44:45], s[54:55], s[52:53]
    s_cselect_b64 s[46:47], s[56:57], s[54:55]
    s_cselect_b64 s[48:49], s[10:11], s[56:57]
    s_xor_b64 s[30:31], s[30:31], s[4:5]
    s_mov_b32 s29, 0x3db8aa3b
    s_mov_b32 s58, 0x22222222
    s_mov_b32 s59, s58
    s_and_b64 s[60:61], s[58:59], s[30:31]
    s_andn2_b64 s[62:63], s[58:59], s[30:31]
    s_lshl_b64 s[64:65], s[58:59], 1
    s_lshl_b64 s[66:67], s[60:61], 1
    s_lshl_b64 s[68:69], s[62:63], 1
    s_lshl_b64 s[70:71], s[64:65], 1
    s_lshl_b64 s[72:73], s[66:67], 1
    s_lshl_b64 s[74:75], s[68:69], 1
    v_mov_b32 v3, 0xff800000
    v_mov_b32 v14, 0xffff
    v_mov_b32 v15, 0
    v_lshlrev_b64 v[4:5], v10, v[14:15]
    v_cndmask_b32 v6, 0, v4, s[30:31]
    v_cndmask_b32 v7, 0, v5, s[30:31]
    v_xor_b32 v8, v4, v6
    v_xor_b32 v9, v5, v7
    s_waitcnt vmcnt(5)
    buffer_load_dwordx4 a[96:99], v1, s[12:15], s52 offen nt
    s_waitcnt vmcnt(5)
    buffer_load_dwordx4 a[100:103], v1, s[12:15], s52 offen offset:256 nt
    s_waitcnt vmcnt(5)
    buffer_load_dwordx4 a[88:91], v1, s[12:15], s51 offen nt
    s_waitcnt vmcnt(5)
    buffer_load_dwordx4 a[92:95], v1, s[12:15], s51 offen offset:256
    s_waitcnt vmcnt(5)
    buffer_load_dwordx4 a[80:83], v1, s[12:15], s50 offen nt
    s_waitcnt vmcnt(5)
    buffer_load_dwordx4 a[84:87], v1, s[12:15], s50 offen offset:256
    s_waitcnt vmcnt(5)
    buffer_load_dwordx4 a[136:139], v1, s[12:15], s57 offen
    buffer_load_dwordx4 a[140:143], v1, s[12:15], s57 offen offset:256 nt
    s_waitcnt vmcnt(6)
    buffer_load_dwordx4 a[128:131], v1, s[12:15], s56 offen nt
    s_waitcnt vmcnt(5)
    buffer_load_dwordx4 a[132:135], v1, s[12:15], s56 offen offset:256
    s_waitcnt vmcnt(4)
    s_waitcnt lgkmcnt(0)
    buffer_load_dwordx4 a[0:3], v1, s[16:19], s40 offen
    buffer_load_dwordx4 a[4:7], v1, s[16:19], s40 offen offset:256
    buffer_load_dwordx4 a[8:11], v1, s[16:19], s41 offen
    buffer_load_dwordx4 a[12:15], v1, s[16:19], s41 offen offset:256
    s_waitcnt vmcnt(7)
    buffer_load_dwordx4 a[16:19], v1, s[16:19], s42 offen
    s_waitcnt vmcnt(7)
    buffer_load_dwordx4 a[20:23], v1, s[16:19], s42 offen offset:256
    s_waitcnt vmcnt(7)
    buffer_load_dwordx4 a[24:27], v1, s[16:19], s43 offen
    buffer_load_dwordx4 a[28:31], v1, s[16:19], s43 offen offset:256
    s_waitcnt vmcnt(7)
    buffer_load_dwordx4 a[32:35], v1, s[16:19], s44 offen
    s_waitcnt vmcnt(5)
    buffer_load_dwordx4 a[36:39], v1, s[16:19], s44 offen offset:256 nt
    s_waitcnt vmcnt(5)
    buffer_load_dwordx4 a[40:43], v1, s[16:19], s45 offen
    v_mfma_f32_16x16x32_bf16 v[32:35], a[0:3], a[80:83], 0
    v_mfma_f32_16x16x32_bf16 v[36:39], a[8:11], a[80:83], 0
    v_mfma_f32_16x16x32_bf16 v[40:43], a[16:19], a[80:83], 0
    s_waitcnt vmcnt(5)
    buffer_load_dwordx4 a[44:47], v1, s[16:19], s45 offen offset:256
    v_mfma_f32_16x16x32_bf16 v[32:35], a[4:7], a[84:87], v[32:35]
    v_mfma_f32_16x16x32_bf16 v[36:39], a[12:15], a[84:87], v[36:39]
    v_mfma_f32_16x16x32_bf16 v[40:43], a[20:23], a[84:87], v[40:43]
    s_waitcnt vmcnt(5)
    buffer_load_dwordx4 a[48:51], v1, s[16:19], s46 offen nt
    v_mfma_f32_16x16x32_bf16 v[44:47], a[8:11], a[88:91], 0
    v_mfma_f32_16x16x32_bf16 v[48:51], a[16:19], a[88:91], 0
    v_mfma_f32_16x16x32_bf16 v[52:55], a[24:27], a[88:91], 0
    s_waitcnt vmcnt(5)
    buffer_load_dwordx4 a[52:55], v1, s[16:19], s46 offen offset:256 nt
    v_mfma_f32_16x16x32_bf16 v[44:47], a[12:15], a[92:95], v[44:47]
    v_mfma_f32_16x16x32_bf16 v[48:51], a[20:23], a[92:95], v[48:51]
    v_mfma_f32_16x16x32_bf16 v[52:55], a[28:31], a[92:95], v[52:55]
    v_add_f32_dpp v10, v33, v32 quad_perm:[1,1,1,1] row_mask:0xf bank_mask:0xf
    v_add_f32_dpp v11, v37, v36 quad_perm:[1,1,1,1] row_mask:0xf bank_mask:0xf
    v_add_f32_dpp v12, v41, v40 quad_perm:[1,1,1,1] row_mask:0xf bank_mask:0xf
    v_add_f32_dpp v10, v34, v10 quad_perm:[2,2,2,2] row_mask:0xf bank_mask:0xf
    v_add_f32_dpp v11, v38, v11 quad_perm:[2,2,2,2] row_mask:0xf bank_mask:0xf
    v_add_f32_dpp v12, v42, v12 quad_perm:[2,2,2,2] row_mask:0xf bank_mask:0xf
    v_add_f32_dpp v10, v35, v10 quad_perm:[3,3,3,3] row_mask:0xf bank_mask:0xf
    v_add_f32_dpp v23, v39, v11 quad_perm:[3,3,3,3] row_mask:0xf bank_mask:0xf
    v_add_f32_dpp v12, v43, v12 quad_perm:[3,3,3,3] row_mask:0xf bank_mask:0xf
    v_cndmask_b32 v22, v12, v10, s[30:31]
    s_waitcnt vmcnt(5)
    buffer_load_dwordx4 a[56:59], v1, s[16:19], s47 offen nt
    v_mfma_f32_16x16x32_bf16 v[32:35], a[16:19], a[96:99], 0
    v_mfma_f32_16x16x32_bf16 v[36:39], a[24:27], a[96:99], 0
    v_mfma_f32_16x16x32_bf16 v[40:43], a[32:35], a[96:99], 0
    s_waitcnt vmcnt(5)
    buffer_load_dwordx4 a[60:63], v1, s[16:19], s47 offen offset:256 nt
    v_mfma_f32_16x16x32_bf16 v[32:35], a[20:23], a[100:103], v[32:35]
    v_mfma_f32_16x16x32_bf16 v[36:39], a[28:31], a[100:103], v[36:39]
    v_mfma_f32_16x16x32_bf16 v[40:43], a[36:39], a[100:103], v[40:43]
    v_add_f32_dpp v10, v44, v45 quad_perm:[0,0,0,0] row_mask:0xf bank_mask:0xf
    v_add_f32_dpp v11, v48, v49 quad_perm:[0,0,0,0] row_mask:0xf bank_mask:0xf
    v_add_f32_dpp v12, v52, v53 quad_perm:[0,0,0,0] row_mask:0xf bank_mask:0xf
    v_add_f32_dpp v10, v46, v10 quad_perm:[2,2,2,2] row_mask:0xf bank_mask:0xf
    v_add_f32_dpp v11, v50, v11 quad_perm:[2,2,2,2] row_mask:0xf bank_mask:0xf
    v_add_f32_dpp v12, v54, v12 quad_perm:[2,2,2,2] row_mask:0xf bank_mask:0xf
    v_add_f32_dpp v10, v47, v10 quad_perm:[3,3,3,3] row_mask:0xf bank_mask:0xf
    v_add_f32_dpp v11, v51, v11 quad_perm:[3,3,3,3] row_mask:0xf bank_mask:0xf
    v_add_f32_dpp v12, v55, v12 quad_perm:[3,3,3,3] row_mask:0xf bank_mask:0xf
    v_cndmask_b32 v22, v22, v10, s[60:61]
    v_cndmask_b32 v23, v23, v11, s[58:59]
    v_cndmask_b32 v22, v22, v12, s[62:63]
    s_waitcnt vmcnt(5)
    buffer_load_dwordx4 a[64:67], v1, s[16:19], s48 offen
    buffer_load_dwordx4 a[68:71], v1, s[16:19], s48 offen offset:256
    buffer_load_dwordx4 a[72:75], v1, s[16:19], s49 offen
    buffer_load_dwordx4 a[76:79], v1, s[16:19], s49 offen offset:256
    v_mfma_f32_16x16x32_bf16 v[44:47], a[24:27], a[104:107], 0
    v_mfma_f32_16x16x32_bf16 v[48:51], a[32:35], a[104:107], 0
    v_mfma_f32_16x16x32_bf16 v[52:55], a[40:43], a[104:107], 0
    s_waitcnt vmcnt(8)
    v_mfma_f32_16x16x32_bf16 v[44:47], a[28:31], a[108:111], v[44:47]
    v_mfma_f32_16x16x32_bf16 v[48:51], a[36:39], a[108:111], v[48:51]
    v_mfma_f32_16x16x32_bf16 v[52:55], a[44:47], a[108:111], v[52:55]
    v_add_f32_dpp v10, v32, v34 quad_perm:[0,0,0,0] row_mask:0xf bank_mask:0xf
    v_add_f32_dpp v11, v36, v38 quad_perm:[0,0,0,0] row_mask:0xf bank_mask:0xf
    v_add_f32_dpp v12, v40, v42 quad_perm:[0,0,0,0] row_mask:0xf bank_mask:0xf
    v_add_f32_dpp v10, v33, v10 quad_perm:[1,1,1,1] row_mask:0xf bank_mask:0xf
    v_add_f32_dpp v11, v37, v11 quad_perm:[1,1,1,1] row_mask:0xf bank_mask:0xf
    v_add_f32_dpp v12, v41, v12 quad_perm:[1,1,1,1] row_mask:0xf bank_mask:0xf
    v_add_f32_dpp v10, v35, v10 quad_perm:[3,3,3,3] row_mask:0xf bank_mask:0xf
    v_add_f32_dpp v11, v39, v11 quad_perm:[3,3,3,3] row_mask:0xf bank_mask:0xf
    v_add_f32_dpp v12, v43, v12 quad_perm:[3,3,3,3] row_mask:0xf bank_mask:0xf
    v_cndmask_b32 v22, v22, v10, s[66:67]
    v_cndmask_b32 v23, v23, v11, s[64:65]
    v_cndmask_b32 v22, v22, v12, s[68:69]
    v_add_f32_dpp v10, v44, v47 quad_perm:[0,0,0,0] row_mask:0xf bank_mask:0xf
    v_add_f32_dpp v11, v48, v51 quad_perm:[0,0,0,0] row_mask:0xf bank_mask:0xf
    v_add_f32_dpp v12, v52, v55 quad_perm:[0,0,0,0] row_mask:0xf bank_mask:0xf
    v_add_f32_dpp v10, v45, v10 quad_perm:[1,1,1,1] row_mask:0xf bank_mask:0xf
    v_add_f32_dpp v11, v49, v11 quad_perm:[1,1,1,1] row_mask:0xf bank_mask:0xf
    v_add_f32_dpp v12, v53, v12 quad_perm:[1,1,1,1] row_mask:0xf bank_mask:0xf
    v_add_f32_dpp v10, v46, v10 quad_perm:[2,2,2,2] row_mask:0xf bank_mask:0xf
    v_add_f32_dpp v11, v50, v11 quad_perm:[2,2,2,2] row_mask:0xf bank_mask:0xf
    v_add_f32_dpp v12, v54, v12 quad_perm:[2,2,2,2] row_mask:0xf bank_mask:0xf
    v_cndmask_b32 v22, v22, v10, s[72:73]
    v_cndmask_b32 v23, v23, v11, s[70:71]
    v_cndmask_b32 v22, v22, v12, s[74:75]
    v_cvt_pk_bf16_f32 v15, v22, v23
    v_lshlrev_b32 v13, 16, v15
    v_and_b32 v14, 0xffff0000, v15
    v_cndmask_b32 v13, v13, v3, s[32:33]
    v_cndmask_b32 v14, v14, v3, s[34:35]
    v_max_f32 v16, v13, v14
    v_max_f32 v17, v13, v14
    s_nop 1
    v_permlane32_swap_b32 v16, v17
    v_max_f32 v15, v16, v17
    v_max_f32 v17, v16, v17
    s_nop 1
    v_permlane16_swap_b32 v15, v17
    v_max_f32 v16, v15, v17
    v_sub_f32 v13, v13, v16
    v_sub_f32 v14, v14, v16
    v_mul_f32 v13, s29, v13
    v_mul_f32 v14, s29, v14
    v_exp_f32 v13, v13
    v_exp_f32 v14, v14
    s_nop 0
    v_add_f32 v16, v13, v14
    v_add_f32 v17, v13, v14
    s_nop 1
    v_permlane32_swap_b32 v16, v17
    v_add_f32 v15, v16, v17
    v_add_f32 v17, v16, v17
    s_nop 1
    v_permlane16_swap_b32 v15, v17
    v_add_f32 v16, v15, v17
    v_rcp_f32 v16, v16
    s_nop 0
    v_mul_f32 v13, v13, v16
    v_mul_f32 v14, v14, v16
    v_cvt_pk_bf16_f32 v18, v13, v13
    v_cvt_pk_bf16_f32 v19, v14, v14
    s_waitcnt vmcnt(7)
    buffer_load_dwordx4 v[152:155], v2, s[20:23], s40 offen
    buffer_load_dwordx4 v[156:159], v2, s[20:23], s40 offen offset:256
    buffer_load_dwordx4 v[160:163], v2, s[20:23], s41 offen
    v_mfma_f32_16x16x32_bf16 v[32:35], a[32:35], a[112:115], 0
    v_mfma_f32_16x16x32_bf16 v[36:39], a[40:43], a[112:115], 0
    v_mfma_f32_16x16x32_bf16 v[40:43], a[48:51], a[112:115], 0
    s_waitcnt vmcnt(9)
    buffer_load_dwordx4 v[164:167], v2, s[20:23], s41 offen offset:256
    v_mfma_f32_16x16x32_bf16 v[32:35], a[36:39], a[116:119], v[32:35]
    v_mfma_f32_16x16x32_bf16 v[36:39], a[44:47], a[116:119], v[36:39]
    v_mfma_f32_16x16x32_bf16 v[40:43], a[52:55], a[116:119], v[40:43]
    s_waitcnt vmcnt(9)
    buffer_load_dwordx4 v[168:171], v2, s[20:23], s42 offen
    v_mfma_f32_16x16x32_bf16 v[44:47], a[40:43], a[120:123], 0
    v_mfma_f32_16x16x32_bf16 v[48:51], a[48:51], a[120:123], 0
    v_mfma_f32_16x16x32_bf16 v[52:55], a[56:59], a[120:123], 0
    s_waitcnt vmcnt(9)
    buffer_load_dwordx4 v[172:175], v2, s[20:23], s42 offen offset:256
    v_mfma_f32_16x16x32_bf16 v[44:47], a[44:47], a[124:127], v[44:47]
    v_mfma_f32_16x16x32_bf16 v[48:51], a[52:55], a[124:127], v[48:51]
    v_mfma_f32_16x16x32_bf16 v[52:55], a[60:63], a[124:127], v[52:55]
    v_add_f32_dpp v10, v33, v32 quad_perm:[1,1,1,1] row_mask:0xf bank_mask:0xf
    v_add_f32_dpp v11, v37, v36 quad_perm:[1,1,1,1] row_mask:0xf bank_mask:0xf
    v_add_f32_dpp v12, v41, v40 quad_perm:[1,1,1,1] row_mask:0xf bank_mask:0xf
    v_add_f32_dpp v10, v34, v10 quad_perm:[2,2,2,2] row_mask:0xf bank_mask:0xf
    v_add_f32_dpp v11, v38, v11 quad_perm:[2,2,2,2] row_mask:0xf bank_mask:0xf
    v_add_f32_dpp v12, v42, v12 quad_perm:[2,2,2,2] row_mask:0xf bank_mask:0xf
    v_add_f32_dpp v10, v35, v10 quad_perm:[3,3,3,3] row_mask:0xf bank_mask:0xf
    v_add_f32_dpp v23, v39, v11 quad_perm:[3,3,3,3] row_mask:0xf bank_mask:0xf
    v_add_f32_dpp v12, v43, v12 quad_perm:[3,3,3,3] row_mask:0xf bank_mask:0xf
    v_cndmask_b32 v22, v12, v10, s[30:31]
    s_waitcnt vmcnt(9)
    buffer_load_dwordx4 v[176:179], v2, s[20:23], s43 offen
    v_mfma_f32_16x16x32_bf16 v[32:35], a[48:51], a[128:131], 0
    v_mfma_f32_16x16x32_bf16 v[36:39], a[56:59], a[128:131], 0
    v_mfma_f32_16x16x32_bf16 v[40:43], a[64:67], a[128:131], 0
    s_waitcnt vmcnt(9)
    v_mfma_f32_16x16x32_bf16 v[32:35], a[52:55], a[132:135], v[32:35]
    v_mfma_f32_16x16x32_bf16 v[36:39], a[60:63], a[132:135], v[36:39]
    v_mfma_f32_16x16x32_bf16 v[40:43], a[68:71], a[132:135], v[40:43]
    v_add_f32_dpp v10, v44, v45 quad_perm:[0,0,0,0] row_mask:0xf bank_mask:0xf
    v_add_f32_dpp v11, v48, v49 quad_perm:[0,0,0,0] row_mask:0xf bank_mask:0xf
    v_add_f32_dpp v12, v52, v53 quad_perm:[0,0,0,0] row_mask:0xf bank_mask:0xf
    v_add_f32_dpp v10, v46, v10 quad_perm:[2,2,2,2] row_mask:0xf bank_mask:0xf
    v_add_f32_dpp v11, v50, v11 quad_perm:[2,2,2,2] row_mask:0xf bank_mask:0xf
    v_add_f32_dpp v12, v54, v12 quad_perm:[2,2,2,2] row_mask:0xf bank_mask:0xf
    v_add_f32_dpp v10, v47, v10 quad_perm:[3,3,3,3] row_mask:0xf bank_mask:0xf
    v_add_f32_dpp v11, v51, v11 quad_perm:[3,3,3,3] row_mask:0xf bank_mask:0xf
    v_add_f32_dpp v12, v55, v12 quad_perm:[3,3,3,3] row_mask:0xf bank_mask:0xf
    v_cndmask_b32 v22, v22, v10, s[60:61]
    v_cndmask_b32 v23, v23, v11, s[58:59]
    v_cndmask_b32 v22, v22, v12, s[62:63]
    s_waitcnt vmcnt(8)
    v_mfma_f32_16x16x32_bf16 v[44:47], a[56:59], a[136:139], 0
    v_mfma_f32_16x16x32_bf16 v[48:51], a[64:67], a[136:139], 0
    v_mfma_f32_16x16x32_bf16 v[52:55], a[72:75], a[136:139], 0
    s_waitcnt vmcnt(7)
    v_mfma_f32_16x16x32_bf16 v[44:47], a[60:63], a[140:143], v[44:47]
    v_mfma_f32_16x16x32_bf16 v[48:51], a[68:71], a[140:143], v[48:51]
    v_mfma_f32_16x16x32_bf16 v[52:55], a[76:79], a[140:143], v[52:55]
    v_add_f32_dpp v10, v32, v34 quad_perm:[0,0,0,0] row_mask:0xf bank_mask:0xf
    v_add_f32_dpp v11, v36, v38 quad_perm:[0,0,0,0] row_mask:0xf bank_mask:0xf
    v_add_f32_dpp v12, v40, v42 quad_perm:[0,0,0,0] row_mask:0xf bank_mask:0xf
    v_add_f32_dpp v10, v33, v10 quad_perm:[1,1,1,1] row_mask:0xf bank_mask:0xf
    v_add_f32_dpp v11, v37, v11 quad_perm:[1,1,1,1] row_mask:0xf bank_mask:0xf
    v_add_f32_dpp v12, v41, v12 quad_perm:[1,1,1,1] row_mask:0xf bank_mask:0xf
    v_add_f32_dpp v10, v35, v10 quad_perm:[3,3,3,3] row_mask:0xf bank_mask:0xf
    v_add_f32_dpp v11, v39, v11 quad_perm:[3,3,3,3] row_mask:0xf bank_mask:0xf
    v_add_f32_dpp v12, v43, v12 quad_perm:[3,3,3,3] row_mask:0xf bank_mask:0xf
    v_cndmask_b32 v22, v22, v10, s[66:67]
    v_cndmask_b32 v23, v23, v11, s[64:65]
    v_cndmask_b32 v22, v22, v12, s[68:69]
    v_add_f32_dpp v10, v44, v47 quad_perm:[0,0,0,0] row_mask:0xf bank_mask:0xf
    v_add_f32_dpp v11, v48, v51 quad_perm:[0,0,0,0] row_mask:0xf bank_mask:0xf
    v_add_f32_dpp v12, v52, v55 quad_perm:[0,0,0,0] row_mask:0xf bank_mask:0xf
    v_add_f32_dpp v10, v45, v10 quad_perm:[1,1,1,1] row_mask:0xf bank_mask:0xf
    v_add_f32_dpp v11, v49, v11 quad_perm:[1,1,1,1] row_mask:0xf bank_mask:0xf
    v_add_f32_dpp v12, v53, v12 quad_perm:[1,1,1,1] row_mask:0xf bank_mask:0xf
    v_add_f32_dpp v10, v46, v10 quad_perm:[2,2,2,2] row_mask:0xf bank_mask:0xf
    v_add_f32_dpp v11, v50, v11 quad_perm:[2,2,2,2] row_mask:0xf bank_mask:0xf
    v_add_f32_dpp v12, v54, v12 quad_perm:[2,2,2,2] row_mask:0xf bank_mask:0xf
    v_cndmask_b32 v22, v22, v10, s[72:73]
    v_cndmask_b32 v23, v23, v11, s[70:71]
    v_cndmask_b32 v22, v22, v12, s[74:75]
    v_cvt_pk_bf16_f32 v15, v22, v23
    v_lshlrev_b32 v13, 16, v15
    v_and_b32 v14, 0xffff0000, v15
    v_max_f32 v16, v13, v14
    v_max_f32 v17, v13, v14
    s_nop 1
    v_permlane32_swap_b32 v16, v17
    v_max_f32 v15, v16, v17
    v_max_f32 v17, v16, v17
    s_nop 1
    v_permlane16_swap_b32 v15, v17
    v_max_f32 v16, v15, v17
    v_sub_f32 v13, v13, v16
    v_sub_f32 v14, v14, v16
    v_mul_f32 v13, s29, v13
    v_mul_f32 v14, s29, v14
    v_exp_f32 v13, v13
    v_exp_f32 v14, v14
    s_nop 0
    v_add_f32 v16, v13, v14
    v_add_f32 v17, v13, v14
    s_nop 1
    v_permlane32_swap_b32 v16, v17
    v_add_f32 v15, v16, v17
    v_add_f32 v17, v16, v17
    s_nop 1
    v_permlane16_swap_b32 v15, v17
    v_add_f32 v16, v15, v17
    v_rcp_f32 v16, v16
    s_nop 0
    v_mul_f32 v13, v13, v16
    v_mul_f32 v14, v14, v16
    v_cvt_pk_bf16_f32 v20, v13, v13
    v_cvt_pk_bf16_f32 v21, v14, v14
    v_and_b32_dpp v26, v18, v6 quad_perm:[0,0,0,0] row_mask:0xf bank_mask:0xf
    v_and_b32_dpp v27, v18, v7 quad_perm:[0,0,0,0] row_mask:0xf bank_mask:0xf
    v_and_b32_dpp v28, v19, v4 quad_perm:[0,0,0,0] row_mask:0xf bank_mask:0xf
    v_and_b32_dpp v29, v19, v5 quad_perm:[0,0,0,0] row_mask:0xf bank_mask:0xf
    v_and_b32_dpp v30, v18, v8 quad_perm:[0,0,0,0] row_mask:0xf bank_mask:0xf
    v_and_b32_dpp v31, v18, v9 quad_perm:[0,0,0,0] row_mask:0xf bank_mask:0xf
    s_waitcnt vmcnt(5)
    buffer_load_dwordx4 v[180:183], v2, s[20:23], s43 offen offset:256
    v_mfma_f32_16x16x16_bf16 v[56:59], v[26:27], v[152:153], 0
    v_mfma_f32_16x16x16_bf16 v[60:63], v[26:27], v[154:155], 0
    v_mfma_f32_16x16x16_bf16 v[64:67], v[26:27], v[156:157], 0
    v_mfma_f32_16x16x16_bf16 v[68:71], v[26:27], v[158:159], 0
    s_waitcnt vmcnt(5)
    buffer_load_dwordx4 v[192:195], v2, s[20:23], s45 offen
    s_waitcnt vmcnt(5)
    v_mfma_f32_16x16x16_bf16 v[56:59], v[28:29], v[160:161], v[56:59]
    v_mfma_f32_16x16x16_bf16 v[60:63], v[28:29], v[162:163], v[60:63]
    v_mfma_f32_16x16x16_bf16 v[64:67], v[28:29], v[164:165], v[64:67]
    v_mfma_f32_16x16x16_bf16 v[68:71], v[28:29], v[166:167], v[68:71]
    s_waitcnt vmcnt(4)
    buffer_load_dwordx4 v[196:199], v2, s[20:23], s45 offen offset:256
    v_mfma_f32_16x16x16_bf16 v[56:59], v[30:31], v[168:169], v[56:59]
    v_mfma_f32_16x16x16_bf16 v[60:63], v[30:31], v[170:171], v[60:63]
    s_waitcnt vmcnt(4)
    buffer_load_dwordx4 v[184:187], v2, s[20:23], s44 offen nt
    v_mfma_f32_16x16x16_bf16 v[64:67], v[30:31], v[172:173], v[64:67]
    v_mfma_f32_16x16x16_bf16 v[68:71], v[30:31], v[174:175], v[68:71]
    v_and_b32_dpp v26, v18, v6 quad_perm:[1,1,1,1] row_mask:0xf bank_mask:0xf
    v_and_b32_dpp v27, v18, v7 quad_perm:[1,1,1,1] row_mask:0xf bank_mask:0xf
    v_and_b32_dpp v28, v19, v4 quad_perm:[1,1,1,1] row_mask:0xf bank_mask:0xf
    v_and_b32_dpp v29, v19, v5 quad_perm:[1,1,1,1] row_mask:0xf bank_mask:0xf
    v_mfma_f32_16x16x16_bf16 v[72:75], v[26:27], v[160:161], 0
    v_mfma_f32_16x16x16_bf16 v[76:79], v[26:27], v[162:163], 0
    v_cvt_pk_bf16_f32 v88, v56, v57
    v_cvt_pk_bf16_f32 v89, v58, v59
    v_cvt_pk_bf16_f32 v90, v60, v61
    v_cvt_pk_bf16_f32 v91, v62, v63
    v_mfma_f32_16x16x16_bf16 v[72:75], v[28:29], v[168:169], v[72:75]
    v_mfma_f32_16x16x16_bf16 v[76:79], v[28:29], v[170:171], v[76:79]
    v_and_b32_dpp v30, v18, v8 quad_perm:[1,1,1,1] row_mask:0xf bank_mask:0xf
    v_and_b32_dpp v31, v18, v9 quad_perm:[1,1,1,1] row_mask:0xf bank_mask:0xf
    s_waitcnt vmcnt(4)
    buffer_load_dwordx4 v[188:191], v2, s[20:23], s44 offen offset:256 nt
    v_mfma_f32_16x16x16_bf16 v[72:75], v[30:31], v[176:177], v[72:75]
    v_mfma_f32_16x16x16_bf16 v[76:79], v[30:31], v[178:179], v[76:79]
    v_mfma_f32_16x16x16_bf16 v[80:83], v[26:27], v[164:165], 0
    v_mfma_f32_16x16x16_bf16 v[84:87], v[26:27], v[166:167], 0
    v_cvt_pk_bf16_f32 v92, v64, v65
    v_cvt_pk_bf16_f32 v93, v66, v67
    v_cvt_pk_bf16_f32 v94, v68, v69
    v_cvt_pk_bf16_f32 v95, v70, v71
    v_mfma_f32_16x16x16_bf16 v[80:83], v[28:29], v[172:173], v[80:83]
    v_mfma_f32_16x16x16_bf16 v[84:87], v[28:29], v[174:175], v[84:87]
    s_waitcnt vmcnt(4)
    buffer_load_dwordx4 v[200:203], v2, s[20:23], s46 offen nt
    v_mfma_f32_16x16x16_bf16 v[80:83], v[30:31], v[180:181], v[80:83]
    v_mfma_f32_16x16x16_bf16 v[84:87], v[30:31], v[182:183], v[84:87]
    v_and_b32_dpp v26, v18, v6 quad_perm:[2,2,2,2] row_mask:0xf bank_mask:0xf
    v_and_b32_dpp v27, v18, v7 quad_perm:[2,2,2,2] row_mask:0xf bank_mask:0xf
    v_and_b32_dpp v28, v19, v4 quad_perm:[2,2,2,2] row_mask:0xf bank_mask:0xf
    v_and_b32_dpp v29, v19, v5 quad_perm:[2,2,2,2] row_mask:0xf bank_mask:0xf
    v_mfma_f32_16x16x16_bf16 v[56:59], v[26:27], v[168:169], 0
    v_mfma_f32_16x16x16_bf16 v[60:63], v[26:27], v[170:171], 0
    v_cvt_pk_bf16_f32 v96, v72, v73
    v_cvt_pk_bf16_f32 v97, v74, v75
    v_cvt_pk_bf16_f32 v98, v76, v77
    v_cvt_pk_bf16_f32 v99, v78, v79
    v_mfma_f32_16x16x16_bf16 v[56:59], v[28:29], v[176:177], v[56:59]
    v_mfma_f32_16x16x16_bf16 v[60:63], v[28:29], v[178:179], v[60:63]
    v_and_b32_dpp v30, v18, v8 quad_perm:[2,2,2,2] row_mask:0xf bank_mask:0xf
    v_and_b32_dpp v31, v18, v9 quad_perm:[2,2,2,2] row_mask:0xf bank_mask:0xf
    s_waitcnt vmcnt(4)
    buffer_load_dwordx4 v[204:207], v2, s[20:23], s46 offen offset:256 nt
    s_waitcnt vmcnt(4)
    buffer_load_dwordx4 v[208:211], v2, s[20:23], s47 offen nt
    s_waitcnt vmcnt(4)
    buffer_load_dwordx4 v[212:215], v2, s[20:23], s47 offen offset:256 nt
    v_mfma_f32_16x16x16_bf16 v[56:59], v[30:31], v[184:185], v[56:59]
    v_mfma_f32_16x16x16_bf16 v[60:63], v[30:31], v[186:187], v[60:63]
    v_mfma_f32_16x16x16_bf16 v[64:67], v[26:27], v[172:173], 0
    v_mfma_f32_16x16x16_bf16 v[68:71], v[26:27], v[174:175], 0
    v_cvt_pk_bf16_f32 v100, v80, v81
    v_cvt_pk_bf16_f32 v101, v82, v83
    v_cvt_pk_bf16_f32 v102, v84, v85
    v_cvt_pk_bf16_f32 v103, v86, v87
    v_mfma_f32_16x16x16_bf16 v[64:67], v[28:29], v[180:181], v[64:67]
    v_mfma_f32_16x16x16_bf16 v[68:71], v[28:29], v[182:183], v[68:71]
    s_waitcnt vmcnt(4)
    buffer_load_dwordx4 v[224:227], v2, s[20:23], s49 offen
    buffer_load_dwordx4 v[228:231], v2, s[20:23], s49 offen offset:256
    buffer_load_dwordx4 v[216:219], v2, s[20:23], s48 offen
    buffer_load_dwordx4 v[220:223], v2, s[20:23], s48 offen offset:256
    v_mfma_f32_16x16x16_bf16 v[64:67], v[30:31], v[188:189], v[64:67]
    v_mfma_f32_16x16x16_bf16 v[68:71], v[30:31], v[190:191], v[68:71]
    v_and_b32_dpp v26, v18, v6 quad_perm:[3,3,3,3] row_mask:0xf bank_mask:0xf
    v_and_b32_dpp v27, v18, v7 quad_perm:[3,3,3,3] row_mask:0xf bank_mask:0xf
    v_and_b32_dpp v28, v19, v4 quad_perm:[3,3,3,3] row_mask:0xf bank_mask:0xf
    v_and_b32_dpp v29, v19, v5 quad_perm:[3,3,3,3] row_mask:0xf bank_mask:0xf
    v_mfma_f32_16x16x16_bf16 v[72:75], v[26:27], v[176:177], 0
    v_mfma_f32_16x16x16_bf16 v[76:79], v[26:27], v[178:179], 0
    v_cvt_pk_bf16_f32 v104, v56, v57
    v_cvt_pk_bf16_f32 v105, v58, v59
    v_cvt_pk_bf16_f32 v106, v60, v61
    v_cvt_pk_bf16_f32 v107, v62, v63
    v_mfma_f32_16x16x16_bf16 v[72:75], v[28:29], v[184:185], v[72:75]
    v_mfma_f32_16x16x16_bf16 v[76:79], v[28:29], v[186:187], v[76:79]
    v_and_b32_dpp v30, v18, v8 quad_perm:[3,3,3,3] row_mask:0xf bank_mask:0xf
    v_and_b32_dpp v31, v18, v9 quad_perm:[3,3,3,3] row_mask:0xf bank_mask:0xf
    s_nop 1
    v_mfma_f32_16x16x16_bf16 v[72:75], v[30:31], v[192:193], v[72:75]
    v_mfma_f32_16x16x16_bf16 v[76:79], v[30:31], v[194:195], v[76:79]
    v_mfma_f32_16x16x16_bf16 v[80:83], v[26:27], v[180:181], 0
    v_mfma_f32_16x16x16_bf16 v[84:87], v[26:27], v[182:183], 0
    v_cvt_pk_bf16_f32 v108, v64, v65
    v_cvt_pk_bf16_f32 v109, v66, v67
    v_cvt_pk_bf16_f32 v110, v68, v69
    v_cvt_pk_bf16_f32 v111, v70, v71
    v_mfma_f32_16x16x16_bf16 v[80:83], v[28:29], v[188:189], v[80:83]
    v_mfma_f32_16x16x16_bf16 v[84:87], v[28:29], v[190:191], v[84:87]
    v_mfma_f32_16x16x16_bf16 v[80:83], v[30:31], v[196:197], v[80:83]
    v_mfma_f32_16x16x16_bf16 v[84:87], v[30:31], v[198:199], v[84:87]
    v_and_b32_dpp v26, v20, v6 quad_perm:[0,0,0,0] row_mask:0xf bank_mask:0xf
    v_and_b32_dpp v27, v20, v7 quad_perm:[0,0,0,0] row_mask:0xf bank_mask:0xf
    v_and_b32_dpp v28, v21, v4 quad_perm:[0,0,0,0] row_mask:0xf bank_mask:0xf
    v_and_b32_dpp v29, v21, v5 quad_perm:[0,0,0,0] row_mask:0xf bank_mask:0xf
    v_mfma_f32_16x16x16_bf16 v[56:59], v[26:27], v[184:185], 0
    v_mfma_f32_16x16x16_bf16 v[60:63], v[26:27], v[186:187], 0
    v_cvt_pk_bf16_f32 v112, v72, v73
    v_cvt_pk_bf16_f32 v113, v74, v75
    v_cvt_pk_bf16_f32 v114, v76, v77
    v_cvt_pk_bf16_f32 v115, v78, v79
    v_mfma_f32_16x16x16_bf16 v[56:59], v[28:29], v[192:193], v[56:59]
    v_mfma_f32_16x16x16_bf16 v[60:63], v[28:29], v[194:195], v[60:63]
    v_and_b32_dpp v30, v20, v8 quad_perm:[0,0,0,0] row_mask:0xf bank_mask:0xf
    v_and_b32_dpp v31, v20, v9 quad_perm:[0,0,0,0] row_mask:0xf bank_mask:0xf
    s_waitcnt vmcnt(7)
    s_nop 0
    v_mfma_f32_16x16x16_bf16 v[56:59], v[30:31], v[200:201], v[56:59]
    v_mfma_f32_16x16x16_bf16 v[60:63], v[30:31], v[202:203], v[60:63]
    v_mfma_f32_16x16x16_bf16 v[64:67], v[26:27], v[188:189], 0
    v_mfma_f32_16x16x16_bf16 v[68:71], v[26:27], v[190:191], 0
    v_cvt_pk_bf16_f32 v116, v80, v81
    v_cvt_pk_bf16_f32 v117, v82, v83
    v_cvt_pk_bf16_f32 v118, v84, v85
    v_cvt_pk_bf16_f32 v119, v86, v87
    v_mfma_f32_16x16x16_bf16 v[64:67], v[28:29], v[196:197], v[64:67]
    v_mfma_f32_16x16x16_bf16 v[68:71], v[28:29], v[198:199], v[68:71]
    s_waitcnt vmcnt(6)
    v_mfma_f32_16x16x16_bf16 v[64:67], v[30:31], v[204:205], v[64:67]
    v_mfma_f32_16x16x16_bf16 v[68:71], v[30:31], v[206:207], v[68:71]
    v_and_b32_dpp v26, v20, v6 quad_perm:[1,1,1,1] row_mask:0xf bank_mask:0xf
    v_and_b32_dpp v27, v20, v7 quad_perm:[1,1,1,1] row_mask:0xf bank_mask:0xf
    v_and_b32_dpp v28, v21, v4 quad_perm:[1,1,1,1] row_mask:0xf bank_mask:0xf
    v_and_b32_dpp v29, v21, v5 quad_perm:[1,1,1,1] row_mask:0xf bank_mask:0xf
    v_mfma_f32_16x16x16_bf16 v[72:75], v[26:27], v[192:193], 0
    v_mfma_f32_16x16x16_bf16 v[76:79], v[26:27], v[194:195], 0
    v_cvt_pk_bf16_f32 v120, v56, v57
    v_cvt_pk_bf16_f32 v121, v58, v59
    v_cvt_pk_bf16_f32 v122, v60, v61
    v_cvt_pk_bf16_f32 v123, v62, v63
    v_mfma_f32_16x16x16_bf16 v[72:75], v[28:29], v[200:201], v[72:75]
    v_mfma_f32_16x16x16_bf16 v[76:79], v[28:29], v[202:203], v[76:79]
    v_and_b32_dpp v30, v20, v8 quad_perm:[1,1,1,1] row_mask:0xf bank_mask:0xf
    v_and_b32_dpp v31, v20, v9 quad_perm:[1,1,1,1] row_mask:0xf bank_mask:0xf
    s_waitcnt vmcnt(5)
    s_nop 0
    v_mfma_f32_16x16x16_bf16 v[72:75], v[30:31], v[208:209], v[72:75]
    v_mfma_f32_16x16x16_bf16 v[76:79], v[30:31], v[210:211], v[76:79]
    v_mfma_f32_16x16x16_bf16 v[80:83], v[26:27], v[196:197], 0
    v_mfma_f32_16x16x16_bf16 v[84:87], v[26:27], v[198:199], 0
    v_cvt_pk_bf16_f32 v124, v64, v65
    v_cvt_pk_bf16_f32 v125, v66, v67
    v_cvt_pk_bf16_f32 v126, v68, v69
    v_cvt_pk_bf16_f32 v127, v70, v71
    v_mfma_f32_16x16x16_bf16 v[80:83], v[28:29], v[204:205], v[80:83]
    v_mfma_f32_16x16x16_bf16 v[84:87], v[28:29], v[206:207], v[84:87]
    s_waitcnt vmcnt(4)
    v_mfma_f32_16x16x16_bf16 v[80:83], v[30:31], v[212:213], v[80:83]
    v_mfma_f32_16x16x16_bf16 v[84:87], v[30:31], v[214:215], v[84:87]
    v_and_b32_dpp v26, v20, v6 quad_perm:[2,2,2,2] row_mask:0xf bank_mask:0xf
    v_and_b32_dpp v27, v20, v7 quad_perm:[2,2,2,2] row_mask:0xf bank_mask:0xf
    v_and_b32_dpp v28, v21, v4 quad_perm:[2,2,2,2] row_mask:0xf bank_mask:0xf
    v_and_b32_dpp v29, v21, v5 quad_perm:[2,2,2,2] row_mask:0xf bank_mask:0xf
    v_mfma_f32_16x16x16_bf16 v[56:59], v[26:27], v[200:201], 0
    v_mfma_f32_16x16x16_bf16 v[60:63], v[26:27], v[202:203], 0
    v_cvt_pk_bf16_f32 v128, v72, v73
    v_cvt_pk_bf16_f32 v129, v74, v75
    v_cvt_pk_bf16_f32 v130, v76, v77
    v_cvt_pk_bf16_f32 v131, v78, v79
    buffer_store_dwordx4 v[88:91], v2, s[24:27], s50 offen nt
    buffer_store_dwordx4 v[92:95], v2, s[24:27], s50 offen offset:256 nt
    v_mfma_f32_16x16x16_bf16 v[56:59], v[28:29], v[208:209], v[56:59]
    v_mfma_f32_16x16x16_bf16 v[60:63], v[28:29], v[210:211], v[60:63]
    v_and_b32_dpp v30, v20, v8 quad_perm:[2,2,2,2] row_mask:0xf bank_mask:0xf
    v_and_b32_dpp v31, v20, v9 quad_perm:[2,2,2,2] row_mask:0xf bank_mask:0xf
    s_waitcnt vmcnt(3)
    s_nop 0
    v_mfma_f32_16x16x16_bf16 v[56:59], v[30:31], v[216:217], v[56:59]
    v_mfma_f32_16x16x16_bf16 v[60:63], v[30:31], v[218:219], v[60:63]
    v_mfma_f32_16x16x16_bf16 v[64:67], v[26:27], v[204:205], 0
    v_mfma_f32_16x16x16_bf16 v[68:71], v[26:27], v[206:207], 0
    v_cvt_pk_bf16_f32 v132, v80, v81
    v_cvt_pk_bf16_f32 v133, v82, v83
    v_cvt_pk_bf16_f32 v134, v84, v85
    v_cvt_pk_bf16_f32 v135, v86, v87
    buffer_store_dwordx4 v[128:131], v2, s[24:27], s55 offen nt
    buffer_store_dwordx4 v[132:135], v2, s[24:27], s55 offen offset:256 nt
    v_mfma_f32_16x16x16_bf16 v[64:67], v[28:29], v[212:213], v[64:67]
    v_mfma_f32_16x16x16_bf16 v[68:71], v[28:29], v[214:215], v[68:71]
    s_waitcnt vmcnt(4)
    v_mfma_f32_16x16x16_bf16 v[64:67], v[30:31], v[220:221], v[64:67]
    v_mfma_f32_16x16x16_bf16 v[68:71], v[30:31], v[222:223], v[68:71]
    v_and_b32_dpp v26, v20, v6 quad_perm:[3,3,3,3] row_mask:0xf bank_mask:0xf
    v_and_b32_dpp v27, v20, v7 quad_perm:[3,3,3,3] row_mask:0xf bank_mask:0xf
    v_and_b32_dpp v28, v21, v4 quad_perm:[3,3,3,3] row_mask:0xf bank_mask:0xf
    v_and_b32_dpp v29, v21, v5 quad_perm:[3,3,3,3] row_mask:0xf bank_mask:0xf
    v_mfma_f32_16x16x16_bf16 v[72:75], v[26:27], v[208:209], 0
    v_mfma_f32_16x16x16_bf16 v[76:79], v[26:27], v[210:211], 0
    v_cvt_pk_bf16_f32 v136, v56, v57
    v_cvt_pk_bf16_f32 v137, v58, v59
    v_cvt_pk_bf16_f32 v138, v60, v61
    v_cvt_pk_bf16_f32 v139, v62, v63
    buffer_store_dwordx4 v[96:99], v2, s[24:27], s51 offen nt
    buffer_store_dwordx4 v[100:103], v2, s[24:27], s51 offen offset:256 nt
    buffer_store_dwordx4 v[104:107], v2, s[24:27], s52 offen nt
    buffer_store_dwordx4 v[108:111], v2, s[24:27], s52 offen offset:256 nt
    v_mfma_f32_16x16x16_bf16 v[72:75], v[28:29], v[216:217], v[72:75]
    v_mfma_f32_16x16x16_bf16 v[76:79], v[28:29], v[218:219], v[76:79]
    v_and_b32_dpp v30, v20, v8 quad_perm:[3,3,3,3] row_mask:0xf bank_mask:0xf
    v_and_b32_dpp v31, v20, v9 quad_perm:[3,3,3,3] row_mask:0xf bank_mask:0xf
    s_nop 1
    v_mfma_f32_16x16x16_bf16 v[72:75], v[30:31], v[224:225], v[72:75]
    v_mfma_f32_16x16x16_bf16 v[76:79], v[30:31], v[226:227], v[76:79]
    v_mfma_f32_16x16x16_bf16 v[80:83], v[26:27], v[212:213], 0
    v_mfma_f32_16x16x16_bf16 v[84:87], v[26:27], v[214:215], 0
    v_cvt_pk_bf16_f32 v140, v64, v65
    v_cvt_pk_bf16_f32 v141, v66, v67
    v_cvt_pk_bf16_f32 v142, v68, v69
    v_cvt_pk_bf16_f32 v143, v70, v71
    buffer_store_dwordx4 v[112:115], v2, s[24:27], s53 offen nt
    buffer_store_dwordx4 v[116:119], v2, s[24:27], s53 offen offset:256 nt
    buffer_store_dwordx4 v[120:123], v2, s[24:27], s54 offen nt
    buffer_store_dwordx4 v[124:127], v2, s[24:27], s54 offen offset:256 nt
    v_mfma_f32_16x16x16_bf16 v[80:83], v[28:29], v[220:221], v[80:83]
    v_mfma_f32_16x16x16_bf16 v[84:87], v[28:29], v[222:223], v[84:87]
    v_mfma_f32_16x16x16_bf16 v[80:83], v[30:31], v[228:229], v[80:83]
    v_mfma_f32_16x16x16_bf16 v[84:87], v[30:31], v[230:231], v[84:87]
    buffer_store_dwordx4 v[136:139], v2, s[24:27], s56 offen nt
    buffer_store_dwordx4 v[140:143], v2, s[24:27], s56 offen offset:256 nt
    v_cvt_pk_bf16_f32 v144, v72, v73
    v_cvt_pk_bf16_f32 v145, v74, v75
    v_cvt_pk_bf16_f32 v146, v76, v77
    v_cvt_pk_bf16_f32 v147, v78, v79
    buffer_store_dwordx4 v[144:147], v2, s[24:27], s57 offen nt
    v_cvt_pk_bf16_f32 v148, v80, v81
    v_cvt_pk_bf16_f32 v149, v82, v83
    v_cvt_pk_bf16_f32 v150, v84, v85
    v_cvt_pk_bf16_f32 v151, v86, v87
    buffer_store_dwordx4 v[148:151], v2, s[24:27], s57 offen offset:256 nt
L_end:
    s_endpgm
.fill (L_pc + 4590 + 7 - .) / 4, 4, 0xbf810000
.section .rodata,"a"
.p2align 6
.amdhsa_kernel standalone__sliding_local_strided__prompt_kernel
  .amdhsa_next_free_vgpr 376
  .amdhsa_next_free_sgpr 76
  .amdhsa_accum_offset 232
  .amdhsa_group_segment_fixed_size 0
  .amdhsa_kernarg_size 48
  .amdhsa_user_sgpr_count 2
  .amdhsa_user_sgpr_kernarg_segment_ptr 1
  .amdhsa_system_sgpr_workgroup_id_x 1
.end_amdhsa_kernel
```
